```python
import torch

def _softmax(x, axis=-1):
    return torch.softmax(x, dim=axis)
def _gelu(x):
    return torch.nn.functional.gelu(x, approximate="tanh")
def _silu(x):
    return torch.nn.functional.silu(x)
def _sigmoid(x):
    return torch.sigmoid(x)
def _layernorm(x, axis=-1, eps=1e-5):
    m = x.mean(dim=axis, keepdim=True)
    v = x.var(dim=axis, keepdim=True, unbiased=False)
    return (x - m) / torch.sqrt(v + eps)
def _scatter_add(tgt, idx, src, axis=0):
    return tgt.clone().index_add_(axis, idx, src)
def _segment_sum(src, seg, n):
    out = torch.zeros((n,) + src.shape[1:], dtype=src.dtype)
    return out.index_add_(0, seg, src)
def _pad(x, pw):
    flat = tuple(v for pair in reversed(pw) for v in pair)
    return torch.nn.functional.pad(x, flat)

kernel_name = 'standalone__channel_attn_se__vision'

def setup_inputs():

    _w = (lambda a: (lambda t: t.to(torch.bfloat16) if t.is_floating_point() else t)(torch.as_tensor(a)))
    H = W = 512
    C = 96
    r = max(C // 16, 4)
    return {
        "x": _w((lambda *s: torch.randn(*s, dtype=torch.bfloat16) * 3.2)(1, H, W, C)),
        "w_down": _w((lambda *s: torch.randn(*s, dtype=torch.bfloat16) * 12.8)(C, r)),
        "w_up": _w((lambda *s: torch.randn(*s, dtype=torch.bfloat16) * 3.2)(r, C)),
    }

def reference(x, w_down, w_up):
    s = x.mean(axis=(1, 2))
    h = _silu(torch.einsum('bc,cr->br', s, w_down))
    g = _sigmoid(torch.einsum('br,rc->bc', h, w_up))
    return x * g[:, None, None, :]
```

```asm
; @launch grid=(256,1,1) block=(768,1,1) lds=50176
.amdgcn_target "amdgcn-amd-amdhsa--gfx950"
.text
.globl standalone__channel_attn_se__vision_kernel
.p2align 8
.type standalone__channel_attn_se__vision_kernel,@function
standalone__channel_attn_se__vision_kernel:
    s_cmp_ge_u32 s2, 256
    s_cbranch_scc1 L_end
    s_load_dwordx4 s[4:7], s[0:1], 0
    s_load_dwordx4 s[8:11], s[0:1], 16
    s_load_dwordx4 s[12:15], s[0:1], 32
    s_mov_b32 s40, 0
    s_mov_b32 s41, 3145728
    s_mov_b32 s42, 6291456
    s_mov_b32 s43, 9437184
    s_mov_b32 s44, 12582912
    s_mov_b32 s45, 15728640
    s_mov_b32 s46, 18874368
    s_mov_b32 s47, 22020096
    s_mov_b32 s48, 25165824
    s_mov_b32 s49, 28311552
    s_mov_b32 s50, 31457280
    s_mov_b32 s51, 34603008
    s_mov_b32 s52, 37748736
    s_mov_b32 s53, 40894464
    s_mov_b32 s54, 44040192
    s_mov_b32 s55, 47185920
    v_lshlrev_b32 v2, 4, v0
    v_lshlrev_b32 v4, 5, v0
    s_mul_i32 s3, s2, 12288
    v_add_u32 v1, s3, v2
    s_mov_b32 s56, 5462
    v_mul_lo_u32 v3, v0, s56
    v_lshrrev_b32 v3, 16, v3
    v_mul_u32_u24 v3, 12, v3
    v_sub_u32 v3, v0, v3
    v_lshlrev_b32 v5, 5, v3
    v_add_u32 v5, 49600, v5
    s_mov_b32 s56, 2731
    v_mul_lo_u32 v3, v0, s56
    v_lshrrev_b32 v3, 16, v3
    v_mul_u32_u24 v3, 384, v3
    v_add_u32 v6, v2, v3
    v_and_b32 v3, 15, v0
    v_mul_u32_u24 v7, 72, v3
    v_lshrrev_b32 v3, 4, v0
    v_lshl_add_u32 v7, v3, 1, v7
    v_lshlrev_b32 v3, 1, v0
    s_waitcnt lgkmcnt(0)
    s_mov_b32 s16, s4
    s_and_b32 s17, s5, 0xffff
    s_mov_b32 s18, 50331648
    s_mov_b32 s19, 0x00020000
    s_mov_b32 s20, s10
    s_and_b32 s21, s11, 0xffff
    s_mov_b32 s22, 50331648
    s_mov_b32 s23, 0x00020000
    s_mov_b32 s24, s14
    s_and_b32 s25, s15, 0xffff
    s_mov_b32 s26, 98304
    s_mov_b32 s27, 0x00020000
    s_mov_b32 s28, s12
    s_and_b32 s29, s13, 0xffff
    s_mov_b32 s30, 256
    s_mov_b32 s31, 0x00020000
    s_mov_b32 s32, s6
    s_and_b32 s33, s7, 0xffff
    s_mov_b32 s34, 1152
    s_mov_b32 s35, 0x00020000
    s_mov_b32 s36, s8
    s_and_b32 s37, s9, 0xffff
    s_mov_b32 s38, 1152
    s_mov_b32 s39, 0x00020000
    s_and_b32 s56, s2, 7
    s_lshl_b32 s56, s56, 7
    s_add_u32 s56, s56, 98304
    v_mov_b32 v9, s56
    s_mov_b32 s26, 99328
    buffer_load_dword v10, v9, s[24:27], 0 offen sc1
    buffer_load_ushort v40, v7, s[32:35], 0 offen offset:0
    buffer_load_ushort v41, v7, s[32:35], 0 offen offset:12
    buffer_load_ushort v42, v7, s[32:35], 0 offen offset:24
    buffer_load_ushort v43, v7, s[32:35], 0 offen offset:36
    buffer_load_ushort v44, v7, s[32:35], 0 offen offset:48
    buffer_load_ushort v45, v7, s[32:35], 0 offen offset:60
    buffer_load_ushort v46, v3, s[36:39], 0 offen offset:0
    buffer_load_ushort v47, v3, s[36:39], 0 offen offset:192
    buffer_load_ushort v48, v3, s[36:39], 0 offen offset:384
    buffer_load_ushort v49, v3, s[36:39], 0 offen offset:576
    buffer_load_ushort v50, v3, s[36:39], 0 offen offset:768
    buffer_load_ushort v51, v3, s[36:39], 0 offen offset:960
    buffer_load_dwordx4 v[64:67], v1, s[16:19], s40 offen nt
    buffer_load_dwordx4 v[68:71], v1, s[16:19], s41 offen nt
    buffer_load_dwordx4 v[72:75], v1, s[16:19], s42 offen nt
    buffer_load_dwordx4 v[76:79], v1, s[16:19], s43 offen nt
    buffer_load_dwordx4 v[80:83], v1, s[16:19], s44 offen nt
    buffer_load_dwordx4 v[84:87], v1, s[16:19], s45 offen nt
    buffer_load_dwordx4 v[88:91], v1, s[16:19], s46 offen nt
    buffer_load_dwordx4 v[92:95], v1, s[16:19], s47 offen nt
    buffer_load_dwordx4 v[96:99], v1, s[16:19], s48 offen nt
    buffer_load_dwordx4 v[100:103], v1, s[16:19], s49 offen nt
    buffer_load_dwordx4 v[104:107], v1, s[16:19], s50 offen nt
    buffer_load_dwordx4 v[108:111], v1, s[16:19], s51 offen nt
    buffer_load_dwordx4 v[112:115], v1, s[16:19], s52 offen nt
    buffer_load_dwordx4 v[116:119], v1, s[16:19], s53 offen nt
    buffer_load_dwordx4 v[120:123], v1, s[16:19], s54 offen nt
    buffer_load_dwordx4 v[124:127], v1, s[16:19], s55 offen nt
    v_mov_b32 v16, 0
    v_mov_b32 v17, 0
    v_mov_b32 v18, 0
    v_mov_b32 v19, 0
    v_mov_b32 v20, 0
    v_mov_b32 v21, 0
    v_mov_b32 v22, 0
    v_mov_b32 v23, 0
    v_mov_b32 v8, 0xffff0000
    s_waitcnt vmcnt(15)
    v_lshlrev_b32 v40, 16, v40
    v_lshlrev_b32 v41, 16, v41
    v_lshlrev_b32 v42, 16, v42
    v_lshlrev_b32 v43, 16, v43
    v_lshlrev_b32 v44, 16, v44
    v_lshlrev_b32 v45, 16, v45
    v_lshlrev_b32 v46, 16, v46
    v_lshlrev_b32 v47, 16, v47
    v_lshlrev_b32 v48, 16, v48
    v_lshlrev_b32 v49, 16, v49
    v_lshlrev_b32 v50, 16, v50
    v_lshlrev_b32 v51, 16, v51
    v_lshlrev_b32 v24, 16, v64
    v_and_b32 v25, v8, v64
    v_add_f32 v16, v16, v24
    v_add_f32 v17, v17, v25
    v_lshlrev_b32 v24, 16, v65
    v_and_b32 v25, v8, v65
    v_add_f32 v18, v18, v24
    v_add_f32 v19, v19, v25
    v_lshlrev_b32 v24, 16, v66
    v_and_b32 v25, v8, v66
    v_add_f32 v20, v20, v24
    v_add_f32 v21, v21, v25
    v_lshlrev_b32 v24, 16, v67
    v_and_b32 v25, v8, v67
    v_add_f32 v22, v22, v24
    v_add_f32 v23, v23, v25
    s_waitcnt vmcnt(14)
    v_lshlrev_b32 v24, 16, v68
    v_and_b32 v25, v8, v68
    v_add_f32 v16, v16, v24
    v_add_f32 v17, v17, v25
    v_lshlrev_b32 v24, 16, v69
    v_and_b32 v25, v8, v69
    v_add_f32 v18, v18, v24
    v_add_f32 v19, v19, v25
    v_lshlrev_b32 v24, 16, v70
    v_and_b32 v25, v8, v70
    v_add_f32 v20, v20, v24
    v_add_f32 v21, v21, v25
    v_lshlrev_b32 v24, 16, v71
    v_and_b32 v25, v8, v71
    v_add_f32 v22, v22, v24
    v_add_f32 v23, v23, v25
    s_waitcnt vmcnt(13)
    v_lshlrev_b32 v24, 16, v72
    v_and_b32 v25, v8, v72
    v_add_f32 v16, v16, v24
    v_add_f32 v17, v17, v25
    v_lshlrev_b32 v24, 16, v73
    v_and_b32 v25, v8, v73
    v_add_f32 v18, v18, v24
    v_add_f32 v19, v19, v25
    v_lshlrev_b32 v24, 16, v74
    v_and_b32 v25, v8, v74
    v_add_f32 v20, v20, v24
    v_add_f32 v21, v21, v25
    v_lshlrev_b32 v24, 16, v75
    v_and_b32 v25, v8, v75
    v_add_f32 v22, v22, v24
    v_add_f32 v23, v23, v25
    s_waitcnt vmcnt(12)
    v_lshlrev_b32 v24, 16, v76
    v_and_b32 v25, v8, v76
    v_add_f32 v16, v16, v24
    v_add_f32 v17, v17, v25
    v_lshlrev_b32 v24, 16, v77
    v_and_b32 v25, v8, v77
    v_add_f32 v18, v18, v24
    v_add_f32 v19, v19, v25
    v_lshlrev_b32 v24, 16, v78
    v_and_b32 v25, v8, v78
    v_add_f32 v20, v20, v24
    v_add_f32 v21, v21, v25
    v_lshlrev_b32 v24, 16, v79
    v_and_b32 v25, v8, v79
    v_add_f32 v22, v22, v24
    v_add_f32 v23, v23, v25
    s_waitcnt vmcnt(11)
    v_lshlrev_b32 v24, 16, v80
    v_and_b32 v25, v8, v80
    v_add_f32 v16, v16, v24
    v_add_f32 v17, v17, v25
    v_lshlrev_b32 v24, 16, v81
    v_and_b32 v25, v8, v81
    v_add_f32 v18, v18, v24
    v_add_f32 v19, v19, v25
    v_lshlrev_b32 v24, 16, v82
    v_and_b32 v25, v8, v82
    v_add_f32 v20, v20, v24
    v_add_f32 v21, v21, v25
    v_lshlrev_b32 v24, 16, v83
    v_and_b32 v25, v8, v83
    v_add_f32 v22, v22, v24
    v_add_f32 v23, v23, v25
    s_waitcnt vmcnt(10)
    v_lshlrev_b32 v24, 16, v84
    v_and_b32 v25, v8, v84
    v_add_f32 v16, v16, v24
    v_add_f32 v17, v17, v25
    v_lshlrev_b32 v24, 16, v85
    v_and_b32 v25, v8, v85
    v_add_f32 v18, v18, v24
    v_add_f32 v19, v19, v25
    v_lshlrev_b32 v24, 16, v86
    v_and_b32 v25, v8, v86
    v_add_f32 v20, v20, v24
    v_add_f32 v21, v21, v25
    v_lshlrev_b32 v24, 16, v87
    v_and_b32 v25, v8, v87
    v_add_f32 v22, v22, v24
    v_add_f32 v23, v23, v25
    s_waitcnt vmcnt(9)
    v_lshlrev_b32 v24, 16, v88
    v_and_b32 v25, v8, v88
    v_add_f32 v16, v16, v24
    v_add_f32 v17, v17, v25
    v_lshlrev_b32 v24, 16, v89
    v_and_b32 v25, v8, v89
    v_add_f32 v18, v18, v24
    v_add_f32 v19, v19, v25
    v_lshlrev_b32 v24, 16, v90
    v_and_b32 v25, v8, v90
    v_add_f32 v20, v20, v24
    v_add_f32 v21, v21, v25
    v_lshlrev_b32 v24, 16, v91
    v_and_b32 v25, v8, v91
    v_add_f32 v22, v22, v24
    v_add_f32 v23, v23, v25
    s_waitcnt vmcnt(8)
    v_lshlrev_b32 v24, 16, v92
    v_and_b32 v25, v8, v92
    v_add_f32 v16, v16, v24
    v_add_f32 v17, v17, v25
    v_lshlrev_b32 v24, 16, v93
    v_and_b32 v25, v8, v93
    v_add_f32 v18, v18, v24
    v_add_f32 v19, v19, v25
    v_lshlrev_b32 v24, 16, v94
    v_and_b32 v25, v8, v94
    v_add_f32 v20, v20, v24
    v_add_f32 v21, v21, v25
    v_lshlrev_b32 v24, 16, v95
    v_and_b32 v25, v8, v95
    v_add_f32 v22, v22, v24
    v_add_f32 v23, v23, v25
    s_waitcnt vmcnt(7)
    v_lshlrev_b32 v24, 16, v96
    v_and_b32 v25, v8, v96
    v_add_f32 v16, v16, v24
    v_add_f32 v17, v17, v25
    v_lshlrev_b32 v24, 16, v97
    v_and_b32 v25, v8, v97
    v_add_f32 v18, v18, v24
    v_add_f32 v19, v19, v25
    v_lshlrev_b32 v24, 16, v98
    v_and_b32 v25, v8, v98
    v_add_f32 v20, v20, v24
    v_add_f32 v21, v21, v25
    v_lshlrev_b32 v24, 16, v99
    v_and_b32 v25, v8, v99
    v_add_f32 v22, v22, v24
    v_add_f32 v23, v23, v25
    s_waitcnt vmcnt(6)
    v_lshlrev_b32 v24, 16, v100
    v_and_b32 v25, v8, v100
    v_add_f32 v16, v16, v24
    v_add_f32 v17, v17, v25
    v_lshlrev_b32 v24, 16, v101
    v_and_b32 v25, v8, v101
    v_add_f32 v18, v18, v24
    v_add_f32 v19, v19, v25
    v_lshlrev_b32 v24, 16, v102
    v_and_b32 v25, v8, v102
    v_add_f32 v20, v20, v24
    v_add_f32 v21, v21, v25
    v_lshlrev_b32 v24, 16, v103
    v_and_b32 v25, v8, v103
    v_add_f32 v22, v22, v24
    v_add_f32 v23, v23, v25
    s_waitcnt vmcnt(5)
    v_lshlrev_b32 v24, 16, v104
    v_and_b32 v25, v8, v104
    v_add_f32 v16, v16, v24
    v_add_f32 v17, v17, v25
    v_lshlrev_b32 v24, 16, v105
    v_and_b32 v25, v8, v105
    v_add_f32 v18, v18, v24
    v_add_f32 v19, v19, v25
    v_lshlrev_b32 v24, 16, v106
    v_and_b32 v25, v8, v106
    v_add_f32 v20, v20, v24
    v_add_f32 v21, v21, v25
    v_lshlrev_b32 v24, 16, v107
    v_and_b32 v25, v8, v107
    v_add_f32 v22, v22, v24
    v_add_f32 v23, v23, v25
    s_waitcnt vmcnt(4)
    v_lshlrev_b32 v24, 16, v108
    v_and_b32 v25, v8, v108
    v_add_f32 v16, v16, v24
    v_add_f32 v17, v17, v25
    v_lshlrev_b32 v24, 16, v109
    v_and_b32 v25, v8, v109
    v_add_f32 v18, v18, v24
    v_add_f32 v19, v19, v25
    v_lshlrev_b32 v24, 16, v110
    v_and_b32 v25, v8, v110
    v_add_f32 v20, v20, v24
    v_add_f32 v21, v21, v25
    v_lshlrev_b32 v24, 16, v111
    v_and_b32 v25, v8, v111
    v_add_f32 v22, v22, v24
    v_add_f32 v23, v23, v25
    s_waitcnt vmcnt(3)
    v_lshlrev_b32 v24, 16, v112
    v_and_b32 v25, v8, v112
    v_add_f32 v16, v16, v24
    v_add_f32 v17, v17, v25
    v_lshlrev_b32 v24, 16, v113
    v_and_b32 v25, v8, v113
    v_add_f32 v18, v18, v24
    v_add_f32 v19, v19, v25
    v_lshlrev_b32 v24, 16, v114
    v_and_b32 v25, v8, v114
    v_add_f32 v20, v20, v24
    v_add_f32 v21, v21, v25
    v_lshlrev_b32 v24, 16, v115
    v_and_b32 v25, v8, v115
    v_add_f32 v22, v22, v24
    v_add_f32 v23, v23, v25
    s_waitcnt vmcnt(2)
    v_lshlrev_b32 v24, 16, v116
    v_and_b32 v25, v8, v116
    v_add_f32 v16, v16, v24
    v_add_f32 v17, v17, v25
    v_lshlrev_b32 v24, 16, v117
    v_and_b32 v25, v8, v117
    v_add_f32 v18, v18, v24
    v_add_f32 v19, v19, v25
    v_lshlrev_b32 v24, 16, v118
    v_and_b32 v25, v8, v118
    v_add_f32 v20, v20, v24
    v_add_f32 v21, v21, v25
    v_lshlrev_b32 v24, 16, v119
    v_and_b32 v25, v8, v119
    v_add_f32 v22, v22, v24
    v_add_f32 v23, v23, v25
    s_waitcnt vmcnt(1)
    v_lshlrev_b32 v24, 16, v120
    v_and_b32 v25, v8, v120
    v_add_f32 v16, v16, v24
    v_add_f32 v17, v17, v25
    v_lshlrev_b32 v24, 16, v121
    v_and_b32 v25, v8, v121
    v_add_f32 v18, v18, v24
    v_add_f32 v19, v19, v25
    v_lshlrev_b32 v24, 16, v122
    v_and_b32 v25, v8, v122
    v_add_f32 v20, v20, v24
    v_add_f32 v21, v21, v25
    v_lshlrev_b32 v24, 16, v123
    v_and_b32 v25, v8, v123
    v_add_f32 v22, v22, v24
    v_add_f32 v23, v23, v25
    s_waitcnt vmcnt(0)
    v_lshlrev_b32 v24, 16, v124
    v_and_b32 v25, v8, v124
    v_add_f32 v16, v16, v24
    v_add_f32 v17, v17, v25
    v_lshlrev_b32 v24, 16, v125
    v_and_b32 v25, v8, v125
    v_add_f32 v18, v18, v24
    v_add_f32 v19, v19, v25
    v_lshlrev_b32 v24, 16, v126
    v_and_b32 v25, v8, v126
    v_add_f32 v20, v20, v24
    v_add_f32 v21, v21, v25
    v_lshlrev_b32 v24, 16, v127
    v_and_b32 v25, v8, v127
    v_add_f32 v22, v22, v24
    v_add_f32 v23, v23, v25
L_reduce:
    ds_write_b128 v4, v[16:19] offset:0
    ds_write_b128 v4, v[20:23] offset:16
    s_waitcnt lgkmcnt(0)
    s_barrier
    ds_read_b128 v[24:27], v6 offset:0
    ds_read_b128 v[28:31], v6 offset:384
    s_waitcnt lgkmcnt(0)
    v_add_f32 v24, v24, v28
    v_add_f32 v25, v25, v29
    v_add_f32 v26, v26, v30
    v_add_f32 v27, v27, v31
    ds_write_b128 v2, v[24:27] offset:24576
    s_waitcnt lgkmcnt(0)
    s_barrier
    v_cmp_gt_u32 vcc, 24, v0
    s_and_saveexec_b64 s[58:59], vcc
    s_cbranch_execz L_after_publish
    v_mov_b32 v24, 0
    v_mov_b32 v25, 0
    v_mov_b32 v26, 0
    v_mov_b32 v27, 0
    ds_read_b128 v[128:131], v2 offset:24576
    ds_read_b128 v[132:135], v2 offset:24960
    ds_read_b128 v[136:139], v2 offset:25344
    ds_read_b128 v[140:143], v2 offset:25728
    ds_read_b128 v[144:147], v2 offset:26112
    ds_read_b128 v[148:151], v2 offset:26496
    ds_read_b128 v[152:155], v2 offset:26880
    ds_read_b128 v[156:159], v2 offset:27264
    s_waitcnt lgkmcnt(7)
    v_add_f32 v24, v24, v128
    v_add_f32 v25, v25, v129
    v_add_f32 v26, v26, v130
    v_add_f32 v27, v27, v131
    s_waitcnt lgkmcnt(6)
    v_add_f32 v24, v24, v132
    v_add_f32 v25, v25, v133
    v_add_f32 v26, v26, v134
    v_add_f32 v27, v27, v135
    s_waitcnt lgkmcnt(5)
    v_add_f32 v24, v24, v136
    v_add_f32 v25, v25, v137
    v_add_f32 v26, v26, v138
    v_add_f32 v27, v27, v139
    s_waitcnt lgkmcnt(4)
    v_add_f32 v24, v24, v140
    v_add_f32 v25, v25, v141
    v_add_f32 v26, v26, v142
    v_add_f32 v27, v27, v143
    s_waitcnt lgkmcnt(3)
    v_add_f32 v24, v24, v144
    v_add_f32 v25, v25, v145
    v_add_f32 v26, v26, v146
    v_add_f32 v27, v27, v147
    s_waitcnt lgkmcnt(2)
    v_add_f32 v24, v24, v148
    v_add_f32 v25, v25, v149
    v_add_f32 v26, v26, v150
    v_add_f32 v27, v27, v151
    s_waitcnt lgkmcnt(1)
    v_add_f32 v24, v24, v152
    v_add_f32 v25, v25, v153
    v_add_f32 v26, v26, v154
    v_add_f32 v27, v27, v155
    s_waitcnt lgkmcnt(0)
    v_add_f32 v24, v24, v156
    v_add_f32 v25, v25, v157
    v_add_f32 v26, v26, v158
    v_add_f32 v27, v27, v159
    ds_read_b128 v[128:131], v2 offset:27648
    ds_read_b128 v[132:135], v2 offset:28032
    ds_read_b128 v[136:139], v2 offset:28416
    ds_read_b128 v[140:143], v2 offset:28800
    ds_read_b128 v[144:147], v2 offset:29184
    ds_read_b128 v[148:151], v2 offset:29568
    ds_read_b128 v[152:155], v2 offset:29952
    ds_read_b128 v[156:159], v2 offset:30336
    s_waitcnt lgkmcnt(7)
    v_add_f32 v24, v24, v128
    v_add_f32 v25, v25, v129
    v_add_f32 v26, v26, v130
    v_add_f32 v27, v27, v131
    s_waitcnt lgkmcnt(6)
    v_add_f32 v24, v24, v132
    v_add_f32 v25, v25, v133
    v_add_f32 v26, v26, v134
    v_add_f32 v27, v27, v135
    s_waitcnt lgkmcnt(5)
    v_add_f32 v24, v24, v136
    v_add_f32 v25, v25, v137
    v_add_f32 v26, v26, v138
    v_add_f32 v27, v27, v139
    s_waitcnt lgkmcnt(4)
    v_add_f32 v24, v24, v140
    v_add_f32 v25, v25, v141
    v_add_f32 v26, v26, v142
    v_add_f32 v27, v27, v143
    s_waitcnt lgkmcnt(3)
    v_add_f32 v24, v24, v144
    v_add_f32 v25, v25, v145
    v_add_f32 v26, v26, v146
    v_add_f32 v27, v27, v147
    s_waitcnt lgkmcnt(2)
    v_add_f32 v24, v24, v148
    v_add_f32 v25, v25, v149
    v_add_f32 v26, v26, v150
    v_add_f32 v27, v27, v151
    s_waitcnt lgkmcnt(1)
    v_add_f32 v24, v24, v152
    v_add_f32 v25, v25, v153
    v_add_f32 v26, v26, v154
    v_add_f32 v27, v27, v155
    s_waitcnt lgkmcnt(0)
    v_add_f32 v24, v24, v156
    v_add_f32 v25, v25, v157
    v_add_f32 v26, v26, v158
    v_add_f32 v27, v27, v159
    ds_read_b128 v[128:131], v2 offset:30720
    ds_read_b128 v[132:135], v2 offset:31104
    ds_read_b128 v[136:139], v2 offset:31488
    ds_read_b128 v[140:143], v2 offset:31872
    ds_read_b128 v[144:147], v2 offset:32256
    ds_read_b128 v[148:151], v2 offset:32640
    ds_read_b128 v[152:155], v2 offset:33024
    ds_read_b128 v[156:159], v2 offset:33408
    s_waitcnt lgkmcnt(7)
    v_add_f32 v24, v24, v128
    v_add_f32 v25, v25, v129
    v_add_f32 v26, v26, v130
    v_add_f32 v27, v27, v131
    s_waitcnt lgkmcnt(6)
    v_add_f32 v24, v24, v132
    v_add_f32 v25, v25, v133
    v_add_f32 v26, v26, v134
    v_add_f32 v27, v27, v135
    s_waitcnt lgkmcnt(5)
    v_add_f32 v24, v24, v136
    v_add_f32 v25, v25, v137
    v_add_f32 v26, v26, v138
    v_add_f32 v27, v27, v139
    s_waitcnt lgkmcnt(4)
    v_add_f32 v24, v24, v140
    v_add_f32 v25, v25, v141
    v_add_f32 v26, v26, v142
    v_add_f32 v27, v27, v143
    s_waitcnt lgkmcnt(3)
    v_add_f32 v24, v24, v144
    v_add_f32 v25, v25, v145
    v_add_f32 v26, v26, v146
    v_add_f32 v27, v27, v147
    s_waitcnt lgkmcnt(2)
    v_add_f32 v24, v24, v148
    v_add_f32 v25, v25, v149
    v_add_f32 v26, v26, v150
    v_add_f32 v27, v27, v151
    s_waitcnt lgkmcnt(1)
    v_add_f32 v24, v24, v152
    v_add_f32 v25, v25, v153
    v_add_f32 v26, v26, v154
    v_add_f32 v27, v27, v155
    s_waitcnt lgkmcnt(0)
    v_add_f32 v24, v24, v156
    v_add_f32 v25, v25, v157
    v_add_f32 v26, v26, v158
    v_add_f32 v27, v27, v159
    ds_read_b128 v[128:131], v2 offset:33792
    ds_read_b128 v[132:135], v2 offset:34176
    ds_read_b128 v[136:139], v2 offset:34560
    ds_read_b128 v[140:143], v2 offset:34944
    ds_read_b128 v[144:147], v2 offset:35328
    ds_read_b128 v[148:151], v2 offset:35712
    ds_read_b128 v[152:155], v2 offset:36096
    ds_read_b128 v[156:159], v2 offset:36480
    s_waitcnt lgkmcnt(7)
    v_add_f32 v24, v24, v128
    v_add_f32 v25, v25, v129
    v_add_f32 v26, v26, v130
    v_add_f32 v27, v27, v131
    s_waitcnt lgkmcnt(6)
    v_add_f32 v24, v24, v132
    v_add_f32 v25, v25, v133
    v_add_f32 v26, v26, v134
    v_add_f32 v27, v27, v135
    s_waitcnt lgkmcnt(5)
    v_add_f32 v24, v24, v136
    v_add_f32 v25, v25, v137
    v_add_f32 v26, v26, v138
    v_add_f32 v27, v27, v139
    s_waitcnt lgkmcnt(4)
    v_add_f32 v24, v24, v140
    v_add_f32 v25, v25, v141
    v_add_f32 v26, v26, v142
    v_add_f32 v27, v27, v143
    s_waitcnt lgkmcnt(3)
    v_add_f32 v24, v24, v144
    v_add_f32 v25, v25, v145
    v_add_f32 v26, v26, v146
    v_add_f32 v27, v27, v147
    s_waitcnt lgkmcnt(2)
    v_add_f32 v24, v24, v148
    v_add_f32 v25, v25, v149
    v_add_f32 v26, v26, v150
    v_add_f32 v27, v27, v151
    s_waitcnt lgkmcnt(1)
    v_add_f32 v24, v24, v152
    v_add_f32 v25, v25, v153
    v_add_f32 v26, v26, v154
    v_add_f32 v27, v27, v155
    s_waitcnt lgkmcnt(0)
    v_add_f32 v24, v24, v156
    v_add_f32 v25, v25, v157
    v_add_f32 v26, v26, v158
    v_add_f32 v27, v27, v159
    s_mul_i32 s56, s2, 384
    v_add_u32 v28, s56, v2
    buffer_store_dwordx4 v[24:27], v28, s[24:27], 0 offen sc1
    s_waitcnt vmcnt(0)
    v_mov_b32 v28, 0
    v_mov_b32 v29, 1
    s_mov_b64 exec, 1
    s_and_b32 s56, s2, 3
    s_lshl_b32 s56, s56, 6
    v_mov_b32 v28, s56
    buffer_atomic_add v29, v28, s[28:31], 0 offen sc0 sc1
    s_mov_b32 s57, 16384
    s_waitcnt vmcnt(0)
    v_readfirstlane_b32 s56, v29
    s_cmp_lg_u32 s56, 63
    s_cbranch_scc1 L_wait
    v_mov_b32 v28, 4
    v_mov_b32 v29, 1
    buffer_atomic_add v29, v28, s[28:31], 0 offen sc0 sc1
    s_waitcnt vmcnt(0)
    v_readfirstlane_b32 s56, v29
    s_cmp_lg_u32 s56, 3
    s_cbranch_scc1 L_wait
    s_mov_b64 exec, 255
    v_lshlrev_b32 v28, 7, v0
    v_add_u32 v28, 98304, v28
    v_readfirstlane_b32 s56, v10
    s_add_u32 s56, s56, 1
    v_mov_b32 v29, s56
    buffer_store_dword v29, v28, s[24:27], 0 offen sc1
    s_mov_b64 exec, 1
    s_branch L_poll_done
L_wait:
    v_readfirstlane_b32 s60, v10
L_poll:
    buffer_load_dword v29, v9, s[24:27], 0 offen sc1
    s_waitcnt vmcnt(0)
    v_readfirstlane_b32 s56, v29
    s_cmp_lg_u32 s56, s60
    s_cbranch_scc1 L_poll_done
    s_sleep 8
    s_sub_u32 s57, s57, 1
    s_cmp_lg_u32 s57, 0
    s_cbranch_scc1 L_poll
L_poll_done:
    v_mov_b32 v28, 0
    s_cmp_eq_u32 s57, 0
    s_cselect_b32 s56, 1, 0
    v_mov_b32 v29, s56
    ds_write_b32 v28, v29 offset:49984
    s_waitcnt lgkmcnt(0)
L_after_publish:
    s_mov_b64 exec, s[58:59]
    s_barrier
    v_mov_b32 v28, 0
    ds_read_b32 v29, v28 offset:49984
    s_waitcnt lgkmcnt(0)
    v_readfirstlane_b32 s56, v29
    s_cmp_lg_u32 s56, 0
    s_cbranch_scc1 L_alone
    s_mov_b32 s56, 0
    buffer_load_dwordx4 v[128:131], v2, s[24:27], s56 offen sc1
    s_mov_b32 s56, 12288
    buffer_load_dwordx4 v[132:135], v2, s[24:27], s56 offen sc1
    s_mov_b32 s56, 24576
    buffer_load_dwordx4 v[136:139], v2, s[24:27], s56 offen sc1
    s_mov_b32 s56, 36864
    buffer_load_dwordx4 v[140:143], v2, s[24:27], s56 offen sc1
    s_mov_b32 s56, 49152
    buffer_load_dwordx4 v[144:147], v2, s[24:27], s56 offen sc1
    s_mov_b32 s56, 61440
    buffer_load_dwordx4 v[148:151], v2, s[24:27], s56 offen sc1
    s_mov_b32 s56, 73728
    buffer_load_dwordx4 v[152:155], v2, s[24:27], s56 offen sc1
    s_mov_b32 s56, 86016
    buffer_load_dwordx4 v[156:159], v2, s[24:27], s56 offen sc1
    s_waitcnt vmcnt(7)
    v_mov_b32 v24, v128
    v_mov_b32 v25, v129
    v_mov_b32 v26, v130
    v_mov_b32 v27, v131
    s_waitcnt vmcnt(6)
    v_add_f32 v24, v24, v132
    v_add_f32 v25, v25, v133
    v_add_f32 v26, v26, v134
    v_add_f32 v27, v27, v135
    s_waitcnt vmcnt(5)
    v_add_f32 v24, v24, v136
    v_add_f32 v25, v25, v137
    v_add_f32 v26, v26, v138
    v_add_f32 v27, v27, v139
    s_waitcnt vmcnt(4)
    v_add_f32 v24, v24, v140
    v_add_f32 v25, v25, v141
    v_add_f32 v26, v26, v142
    v_add_f32 v27, v27, v143
    s_waitcnt vmcnt(3)
    v_add_f32 v24, v24, v144
    v_add_f32 v25, v25, v145
    v_add_f32 v26, v26, v146
    v_add_f32 v27, v27, v147
    s_waitcnt vmcnt(2)
    v_add_f32 v24, v24, v148
    v_add_f32 v25, v25, v149
    v_add_f32 v26, v26, v150
    v_add_f32 v27, v27, v151
    s_waitcnt vmcnt(1)
    v_add_f32 v24, v24, v152
    v_add_f32 v25, v25, v153
    v_add_f32 v26, v26, v154
    v_add_f32 v27, v27, v155
    s_waitcnt vmcnt(0)
    v_add_f32 v24, v24, v156
    v_add_f32 v25, v25, v157
    v_add_f32 v26, v26, v158
    v_add_f32 v27, v27, v159
    ds_write_b128 v2, v[24:27] offset:36864
    s_waitcnt lgkmcnt(0)
    s_barrier
    v_cmp_gt_u32 vcc, 96, v0
    s_and_saveexec_b64 s[58:59], vcc
    s_cbranch_execz L_skip_mean
    v_lshlrev_b32 v28, 2, v0
    v_mov_b32 v24, 0
    ds_read_b32 v52, v28 offset:36864
    ds_read_b32 v53, v28 offset:37248
    ds_read_b32 v54, v28 offset:37632
    ds_read_b32 v55, v28 offset:38016
    ds_read_b32 v56, v28 offset:38400
    ds_read_b32 v57, v28 offset:38784
    ds_read_b32 v58, v28 offset:39168
    ds_read_b32 v59, v28 offset:39552
    s_waitcnt lgkmcnt(0)
    v_add_f32 v24, v24, v52
    v_add_f32 v24, v24, v53
    v_add_f32 v24, v24, v54
    v_add_f32 v24, v24, v55
    v_add_f32 v24, v24, v56
    v_add_f32 v24, v24, v57
    v_add_f32 v24, v24, v58
    v_add_f32 v24, v24, v59
    ds_read_b32 v52, v28 offset:39936
    ds_read_b32 v53, v28 offset:40320
    ds_read_b32 v54, v28 offset:40704
    ds_read_b32 v55, v28 offset:41088
    ds_read_b32 v56, v28 offset:41472
    ds_read_b32 v57, v28 offset:41856
    ds_read_b32 v58, v28 offset:42240
    ds_read_b32 v59, v28 offset:42624
    s_waitcnt lgkmcnt(0)
    v_add_f32 v24, v24, v52
    v_add_f32 v24, v24, v53
    v_add_f32 v24, v24, v54
    v_add_f32 v24, v24, v55
    v_add_f32 v24, v24, v56
    v_add_f32 v24, v24, v57
    v_add_f32 v24, v24, v58
    v_add_f32 v24, v24, v59
    ds_read_b32 v52, v28 offset:43008
    ds_read_b32 v53, v28 offset:43392
    ds_read_b32 v54, v28 offset:43776
    ds_read_b32 v55, v28 offset:44160
    ds_read_b32 v56, v28 offset:44544
    ds_read_b32 v57, v28 offset:44928
    ds_read_b32 v58, v28 offset:45312
    ds_read_b32 v59, v28 offset:45696
    s_waitcnt lgkmcnt(0)
    v_add_f32 v24, v24, v52
    v_add_f32 v24, v24, v53
    v_add_f32 v24, v24, v54
    v_add_f32 v24, v24, v55
    v_add_f32 v24, v24, v56
    v_add_f32 v24, v24, v57
    v_add_f32 v24, v24, v58
    v_add_f32 v24, v24, v59
    ds_read_b32 v52, v28 offset:46080
    ds_read_b32 v53, v28 offset:46464
    ds_read_b32 v54, v28 offset:46848
    ds_read_b32 v55, v28 offset:47232
    ds_read_b32 v56, v28 offset:47616
    ds_read_b32 v57, v28 offset:48000
    ds_read_b32 v58, v28 offset:48384
    ds_read_b32 v59, v28 offset:48768
    s_waitcnt lgkmcnt(0)
    v_add_f32 v24, v24, v52
    v_add_f32 v24, v24, v53
    v_add_f32 v24, v24, v54
    v_add_f32 v24, v24, v55
    v_add_f32 v24, v24, v56
    v_add_f32 v24, v24, v57
    v_add_f32 v24, v24, v58
    v_add_f32 v24, v24, v59
L_mean_tail:
    v_mul_f32 v24, 0x36800000, v24
    v_cvt_pk_bf16_f32 v24, v24, v24
    v_lshlrev_b32 v24, 16, v24
    ds_write_b32 v28, v24 offset:49152
    s_waitcnt lgkmcnt(0)
L_skip_mean:
    s_mov_b64 exec, s[58:59]
    s_barrier
    v_cmp_gt_u32 vcc, 96, v0
    s_and_saveexec_b64 s[58:59], vcc
    s_cbranch_execz L_skip_down
    v_and_b32 v28, 15, v0
    v_mul_u32_u24 v28, 24, v28
    ds_read_b64 v[52:53], v28 offset:49152
    ds_read_b64 v[54:55], v28 offset:49160
    ds_read_b64 v[56:57], v28 offset:49168
    s_waitcnt lgkmcnt(0)
    v_mul_f32 v24, v52, v40
    v_fmac_f32 v24, v53, v41
    v_fmac_f32 v24, v54, v42
    v_fmac_f32 v24, v55, v43
    v_fmac_f32 v24, v56, v44
    v_fmac_f32 v24, v57, v45
    s_nop 1
    v_add_f32_dpp v24, v24, v24 row_shr:1 row_mask:0xf bank_mask:0xf
    s_nop 1
    v_add_f32_dpp v24, v24, v24 row_shr:2 row_mask:0xf bank_mask:0xf
    s_nop 1
    v_add_f32_dpp v24, v24, v24 row_shr:4 row_mask:0xf bank_mask:0xf
    s_nop 1
    v_add_f32_dpp v24, v24, v24 row_shr:8 row_mask:0xf bank_mask:0xf
    v_cvt_pk_bf16_f32 v24, v24, v24
    v_lshlrev_b32 v24, 16, v24
    v_mul_f32 v25, 0xbfb8aa3b, v24
    v_exp_f32 v25, v25
    s_nop 0
    v_add_f32 v25, 1.0, v25
    v_rcp_f32 v25, v25
    s_nop 0
    v_mul_f32 v24, v24, v25
    v_cvt_pk_bf16_f32 v24, v24, v24
    v_lshlrev_b32 v24, 16, v24
    v_and_b32 v28, 15, v0
    v_cmp_eq_u32 vcc, 15, v28
    s_and_b64 exec, exec, vcc
    v_lshrrev_b32 v28, 4, v0
    v_lshlrev_b32 v28, 2, v28
    ds_write_b32 v28, v24 offset:49536
    s_waitcnt lgkmcnt(0)
L_skip_down:
    s_mov_b64 exec, s[58:59]
    s_barrier
    v_cmp_gt_u32 vcc, 96, v0
    s_and_saveexec_b64 s[58:59], vcc
    s_cbranch_execz L_skip_up
    v_mov_b32 v28, 0
    ds_read_b128 v[52:55], v28 offset:49536
    ds_read_b64 v[56:57], v28 offset:49552
    s_waitcnt lgkmcnt(0)
    v_mul_f32 v24, v52, v46
    v_fmac_f32 v24, v53, v47
    v_fmac_f32 v24, v54, v48
    v_fmac_f32 v24, v55, v49
    v_fmac_f32 v24, v56, v50
    v_fmac_f32 v24, v57, v51
    v_cvt_pk_bf16_f32 v24, v24, v24
    v_lshlrev_b32 v24, 16, v24
    v_mul_f32 v25, 0xbfb8aa3b, v24
    v_exp_f32 v25, v25
    s_nop 0
    v_add_f32 v25, 1.0, v25
    v_rcp_f32 v25, v25
    s_nop 0
    v_cvt_pk_bf16_f32 v25, v25, v25
    v_lshlrev_b32 v25, 16, v25
    v_lshlrev_b32 v28, 2, v0
    ds_write_b32 v28, v25 offset:49600
    s_waitcnt lgkmcnt(0)
L_skip_up:
    s_mov_b64 exec, s[58:59]
    s_barrier
    ds_read_b128 v[16:19], v5
    ds_read_b128 v[20:23], v5 offset:16
    v_mov_b32 v8, 0xffff0000
    s_waitcnt lgkmcnt(0)
L_scale:
    v_lshlrev_b32 v24, 16, v64
    v_and_b32 v25, v8, v64
    v_mul_f32 v24, v24, v16
    v_mul_f32 v25, v25, v17
    v_cvt_pk_bf16_f32 v64, v24, v25
    v_lshlrev_b32 v24, 16, v65
    v_and_b32 v25, v8, v65
    v_mul_f32 v24, v24, v18
    v_mul_f32 v25, v25, v19
    v_cvt_pk_bf16_f32 v65, v24, v25
    v_lshlrev_b32 v24, 16, v66
    v_and_b32 v25, v8, v66
    v_mul_f32 v24, v24, v20
    v_mul_f32 v25, v25, v21
    v_cvt_pk_bf16_f32 v66, v24, v25
    v_lshlrev_b32 v24, 16, v67
    v_and_b32 v25, v8, v67
    v_mul_f32 v24, v24, v22
    v_mul_f32 v25, v25, v23
    v_cvt_pk_bf16_f32 v67, v24, v25
    buffer_store_dwordx4 v[64:67], v1, s[20:23], s40 offen sc1
    v_lshlrev_b32 v24, 16, v68
    v_and_b32 v25, v8, v68
    v_mul_f32 v24, v24, v16
    v_mul_f32 v25, v25, v17
    v_cvt_pk_bf16_f32 v68, v24, v25
    v_lshlrev_b32 v24, 16, v69
    v_and_b32 v25, v8, v69
    v_mul_f32 v24, v24, v18
    v_mul_f32 v25, v25, v19
    v_cvt_pk_bf16_f32 v69, v24, v25
    v_lshlrev_b32 v24, 16, v70
    v_and_b32 v25, v8, v70
    v_mul_f32 v24, v24, v20
    v_mul_f32 v25, v25, v21
    v_cvt_pk_bf16_f32 v70, v24, v25
    v_lshlrev_b32 v24, 16, v71
    v_and_b32 v25, v8, v71
    v_mul_f32 v24, v24, v22
    v_mul_f32 v25, v25, v23
    v_cvt_pk_bf16_f32 v71, v24, v25
    buffer_store_dwordx4 v[68:71], v1, s[20:23], s41 offen sc1
    v_lshlrev_b32 v24, 16, v72
    v_and_b32 v25, v8, v72
    v_mul_f32 v24, v24, v16
    v_mul_f32 v25, v25, v17
    v_cvt_pk_bf16_f32 v72, v24, v25
    v_lshlrev_b32 v24, 16, v73
    v_and_b32 v25, v8, v73
    v_mul_f32 v24, v24, v18
    v_mul_f32 v25, v25, v19
    v_cvt_pk_bf16_f32 v73, v24, v25
    v_lshlrev_b32 v24, 16, v74
    v_and_b32 v25, v8, v74
    v_mul_f32 v24, v24, v20
    v_mul_f32 v25, v25, v21
    v_cvt_pk_bf16_f32 v74, v24, v25
    v_lshlrev_b32 v24, 16, v75
    v_and_b32 v25, v8, v75
    v_mul_f32 v24, v24, v22
    v_mul_f32 v25, v25, v23
    v_cvt_pk_bf16_f32 v75, v24, v25
    buffer_store_dwordx4 v[72:75], v1, s[20:23], s42 offen sc1
    v_lshlrev_b32 v24, 16, v76
    v_and_b32 v25, v8, v76
    v_mul_f32 v24, v24, v16
    v_mul_f32 v25, v25, v17
    v_cvt_pk_bf16_f32 v76, v24, v25
    v_lshlrev_b32 v24, 16, v77
    v_and_b32 v25, v8, v77
    v_mul_f32 v24, v24, v18
    v_mul_f32 v25, v25, v19
    v_cvt_pk_bf16_f32 v77, v24, v25
    v_lshlrev_b32 v24, 16, v78
    v_and_b32 v25, v8, v78
    v_mul_f32 v24, v24, v20
    v_mul_f32 v25, v25, v21
    v_cvt_pk_bf16_f32 v78, v24, v25
    v_lshlrev_b32 v24, 16, v79
    v_and_b32 v25, v8, v79
    v_mul_f32 v24, v24, v22
    v_mul_f32 v25, v25, v23
    v_cvt_pk_bf16_f32 v79, v24, v25
    buffer_store_dwordx4 v[76:79], v1, s[20:23], s43 offen sc1
    v_lshlrev_b32 v24, 16, v80
    v_and_b32 v25, v8, v80
    v_mul_f32 v24, v24, v16
    v_mul_f32 v25, v25, v17
    v_cvt_pk_bf16_f32 v80, v24, v25
    v_lshlrev_b32 v24, 16, v81
    v_and_b32 v25, v8, v81
    v_mul_f32 v24, v24, v18
    v_mul_f32 v25, v25, v19
    v_cvt_pk_bf16_f32 v81, v24, v25
    v_lshlrev_b32 v24, 16, v82
    v_and_b32 v25, v8, v82
    v_mul_f32 v24, v24, v20
    v_mul_f32 v25, v25, v21
    v_cvt_pk_bf16_f32 v82, v24, v25
    v_lshlrev_b32 v24, 16, v83
    v_and_b32 v25, v8, v83
    v_mul_f32 v24, v24, v22
    v_mul_f32 v25, v25, v23
    v_cvt_pk_bf16_f32 v83, v24, v25
    buffer_store_dwordx4 v[80:83], v1, s[20:23], s44 offen sc1
    v_lshlrev_b32 v24, 16, v84
    v_and_b32 v25, v8, v84
    v_mul_f32 v24, v24, v16
    v_mul_f32 v25, v25, v17
    v_cvt_pk_bf16_f32 v84, v24, v25
    v_lshlrev_b32 v24, 16, v85
    v_and_b32 v25, v8, v85
    v_mul_f32 v24, v24, v18
    v_mul_f32 v25, v25, v19
    v_cvt_pk_bf16_f32 v85, v24, v25
    v_lshlrev_b32 v24, 16, v86
    v_and_b32 v25, v8, v86
    v_mul_f32 v24, v24, v20
    v_mul_f32 v25, v25, v21
    v_cvt_pk_bf16_f32 v86, v24, v25
    v_lshlrev_b32 v24, 16, v87
    v_and_b32 v25, v8, v87
    v_mul_f32 v24, v24, v22
    v_mul_f32 v25, v25, v23
    v_cvt_pk_bf16_f32 v87, v24, v25
    buffer_store_dwordx4 v[84:87], v1, s[20:23], s45 offen sc1
    v_lshlrev_b32 v24, 16, v88
    v_and_b32 v25, v8, v88
    v_mul_f32 v24, v24, v16
    v_mul_f32 v25, v25, v17
    v_cvt_pk_bf16_f32 v88, v24, v25
    v_lshlrev_b32 v24, 16, v89
    v_and_b32 v25, v8, v89
    v_mul_f32 v24, v24, v18
    v_mul_f32 v25, v25, v19
    v_cvt_pk_bf16_f32 v89, v24, v25
    v_lshlrev_b32 v24, 16, v90
    v_and_b32 v25, v8, v90
    v_mul_f32 v24, v24, v20
    v_mul_f32 v25, v25, v21
    v_cvt_pk_bf16_f32 v90, v24, v25
    v_lshlrev_b32 v24, 16, v91
    v_and_b32 v25, v8, v91
    v_mul_f32 v24, v24, v22
    v_mul_f32 v25, v25, v23
    v_cvt_pk_bf16_f32 v91, v24, v25
    buffer_store_dwordx4 v[88:91], v1, s[20:23], s46 offen sc1
    v_lshlrev_b32 v24, 16, v92
    v_and_b32 v25, v8, v92
    v_mul_f32 v24, v24, v16
    v_mul_f32 v25, v25, v17
    v_cvt_pk_bf16_f32 v92, v24, v25
    v_lshlrev_b32 v24, 16, v93
    v_and_b32 v25, v8, v93
    v_mul_f32 v24, v24, v18
    v_mul_f32 v25, v25, v19
    v_cvt_pk_bf16_f32 v93, v24, v25
    v_lshlrev_b32 v24, 16, v94
    v_and_b32 v25, v8, v94
    v_mul_f32 v24, v24, v20
    v_mul_f32 v25, v25, v21
    v_cvt_pk_bf16_f32 v94, v24, v25
    v_lshlrev_b32 v24, 16, v95
    v_and_b32 v25, v8, v95
    v_mul_f32 v24, v24, v22
    v_mul_f32 v25, v25, v23
    v_cvt_pk_bf16_f32 v95, v24, v25
    buffer_store_dwordx4 v[92:95], v1, s[20:23], s47 offen sc1
    v_lshlrev_b32 v24, 16, v96
    v_and_b32 v25, v8, v96
    v_mul_f32 v24, v24, v16
    v_mul_f32 v25, v25, v17
    v_cvt_pk_bf16_f32 v96, v24, v25
    v_lshlrev_b32 v24, 16, v97
    v_and_b32 v25, v8, v97
    v_mul_f32 v24, v24, v18
    v_mul_f32 v25, v25, v19
    v_cvt_pk_bf16_f32 v97, v24, v25
    v_lshlrev_b32 v24, 16, v98
    v_and_b32 v25, v8, v98
    v_mul_f32 v24, v24, v20
    v_mul_f32 v25, v25, v21
    v_cvt_pk_bf16_f32 v98, v24, v25
    v_lshlrev_b32 v24, 16, v99
    v_and_b32 v25, v8, v99
    v_mul_f32 v24, v24, v22
    v_mul_f32 v25, v25, v23
    v_cvt_pk_bf16_f32 v99, v24, v25
    buffer_store_dwordx4 v[96:99], v1, s[20:23], s48 offen sc1
    v_lshlrev_b32 v24, 16, v100
    v_and_b32 v25, v8, v100
    v_mul_f32 v24, v24, v16
    v_mul_f32 v25, v25, v17
    v_cvt_pk_bf16_f32 v100, v24, v25
    v_lshlrev_b32 v24, 16, v101
    v_and_b32 v25, v8, v101
    v_mul_f32 v24, v24, v18
    v_mul_f32 v25, v25, v19
    v_cvt_pk_bf16_f32 v101, v24, v25
    v_lshlrev_b32 v24, 16, v102
    v_and_b32 v25, v8, v102
    v_mul_f32 v24, v24, v20
    v_mul_f32 v25, v25, v21
    v_cvt_pk_bf16_f32 v102, v24, v25
    v_lshlrev_b32 v24, 16, v103
    v_and_b32 v25, v8, v103
    v_mul_f32 v24, v24, v22
    v_mul_f32 v25, v25, v23
    v_cvt_pk_bf16_f32 v103, v24, v25
    buffer_store_dwordx4 v[100:103], v1, s[20:23], s49 offen sc1
    v_lshlrev_b32 v24, 16, v104
    v_and_b32 v25, v8, v104
    v_mul_f32 v24, v24, v16
    v_mul_f32 v25, v25, v17
    v_cvt_pk_bf16_f32 v104, v24, v25
    v_lshlrev_b32 v24, 16, v105
    v_and_b32 v25, v8, v105
    v_mul_f32 v24, v24, v18
    v_mul_f32 v25, v25, v19
    v_cvt_pk_bf16_f32 v105, v24, v25
    v_lshlrev_b32 v24, 16, v106
    v_and_b32 v25, v8, v106
    v_mul_f32 v24, v24, v20
    v_mul_f32 v25, v25, v21
    v_cvt_pk_bf16_f32 v106, v24, v25
    v_lshlrev_b32 v24, 16, v107
    v_and_b32 v25, v8, v107
    v_mul_f32 v24, v24, v22
    v_mul_f32 v25, v25, v23
    v_cvt_pk_bf16_f32 v107, v24, v25
    buffer_store_dwordx4 v[104:107], v1, s[20:23], s50 offen sc1
    v_lshlrev_b32 v24, 16, v108
    v_and_b32 v25, v8, v108
    v_mul_f32 v24, v24, v16
    v_mul_f32 v25, v25, v17
    v_cvt_pk_bf16_f32 v108, v24, v25
    v_lshlrev_b32 v24, 16, v109
    v_and_b32 v25, v8, v109
    v_mul_f32 v24, v24, v18
    v_mul_f32 v25, v25, v19
    v_cvt_pk_bf16_f32 v109, v24, v25
    v_lshlrev_b32 v24, 16, v110
    v_and_b32 v25, v8, v110
    v_mul_f32 v24, v24, v20
    v_mul_f32 v25, v25, v21
    v_cvt_pk_bf16_f32 v110, v24, v25
    v_lshlrev_b32 v24, 16, v111
    v_and_b32 v25, v8, v111
    v_mul_f32 v24, v24, v22
    v_mul_f32 v25, v25, v23
    v_cvt_pk_bf16_f32 v111, v24, v25
    buffer_store_dwordx4 v[108:111], v1, s[20:23], s51 offen sc1
    v_lshlrev_b32 v24, 16, v112
    v_and_b32 v25, v8, v112
    v_mul_f32 v24, v24, v16
    v_mul_f32 v25, v25, v17
    v_cvt_pk_bf16_f32 v112, v24, v25
    v_lshlrev_b32 v24, 16, v113
    v_and_b32 v25, v8, v113
    v_mul_f32 v24, v24, v18
    v_mul_f32 v25, v25, v19
    v_cvt_pk_bf16_f32 v113, v24, v25
    v_lshlrev_b32 v24, 16, v114
    v_and_b32 v25, v8, v114
    v_mul_f32 v24, v24, v20
    v_mul_f32 v25, v25, v21
    v_cvt_pk_bf16_f32 v114, v24, v25
    v_lshlrev_b32 v24, 16, v115
    v_and_b32 v25, v8, v115
    v_mul_f32 v24, v24, v22
    v_mul_f32 v25, v25, v23
    v_cvt_pk_bf16_f32 v115, v24, v25
    buffer_store_dwordx4 v[112:115], v1, s[20:23], s52 offen sc1
    v_lshlrev_b32 v24, 16, v116
    v_and_b32 v25, v8, v116
    v_mul_f32 v24, v24, v16
    v_mul_f32 v25, v25, v17
    v_cvt_pk_bf16_f32 v116, v24, v25
    v_lshlrev_b32 v24, 16, v117
    v_and_b32 v25, v8, v117
    v_mul_f32 v24, v24, v18
    v_mul_f32 v25, v25, v19
    v_cvt_pk_bf16_f32 v117, v24, v25
    v_lshlrev_b32 v24, 16, v118
    v_and_b32 v25, v8, v118
    v_mul_f32 v24, v24, v20
    v_mul_f32 v25, v25, v21
    v_cvt_pk_bf16_f32 v118, v24, v25
    v_lshlrev_b32 v24, 16, v119
    v_and_b32 v25, v8, v119
    v_mul_f32 v24, v24, v22
    v_mul_f32 v25, v25, v23
    v_cvt_pk_bf16_f32 v119, v24, v25
    buffer_store_dwordx4 v[116:119], v1, s[20:23], s53 offen sc1
    v_lshlrev_b32 v24, 16, v120
    v_and_b32 v25, v8, v120
    v_mul_f32 v24, v24, v16
    v_mul_f32 v25, v25, v17
    v_cvt_pk_bf16_f32 v120, v24, v25
    v_lshlrev_b32 v24, 16, v121
    v_and_b32 v25, v8, v121
    v_mul_f32 v24, v24, v18
    v_mul_f32 v25, v25, v19
    v_cvt_pk_bf16_f32 v121, v24, v25
    v_lshlrev_b32 v24, 16, v122
    v_and_b32 v25, v8, v122
    v_mul_f32 v24, v24, v20
    v_mul_f32 v25, v25, v21
    v_cvt_pk_bf16_f32 v122, v24, v25
    v_lshlrev_b32 v24, 16, v123
    v_and_b32 v25, v8, v123
    v_mul_f32 v24, v24, v22
    v_mul_f32 v25, v25, v23
    v_cvt_pk_bf16_f32 v123, v24, v25
    buffer_store_dwordx4 v[120:123], v1, s[20:23], s54 offen sc1
    v_lshlrev_b32 v24, 16, v124
    v_and_b32 v25, v8, v124
    v_mul_f32 v24, v24, v16
    v_mul_f32 v25, v25, v17
    v_cvt_pk_bf16_f32 v124, v24, v25
    v_lshlrev_b32 v24, 16, v125
    v_and_b32 v25, v8, v125
    v_mul_f32 v24, v24, v18
    v_mul_f32 v25, v25, v19
    v_cvt_pk_bf16_f32 v125, v24, v25
    v_lshlrev_b32 v24, 16, v126
    v_and_b32 v25, v8, v126
    v_mul_f32 v24, v24, v20
    v_mul_f32 v25, v25, v21
    v_cvt_pk_bf16_f32 v126, v24, v25
    v_lshlrev_b32 v24, 16, v127
    v_and_b32 v25, v8, v127
    v_mul_f32 v24, v24, v22
    v_mul_f32 v25, v25, v23
    v_cvt_pk_bf16_f32 v127, v24, v25
    buffer_store_dwordx4 v[124:127], v1, s[20:23], s55 offen sc1
    s_branch L_end
L_alone:
    s_barrier
    v_mov_b32 v16, 0
    v_mov_b32 v17, 0
    v_mov_b32 v18, 0
    v_mov_b32 v19, 0
    v_mov_b32 v20, 0
    v_mov_b32 v21, 0
    v_mov_b32 v22, 0
    v_mov_b32 v23, 0
    v_mov_b32 v8, 0xffff0000
    s_mov_b32 s56, 0
L_alone_loop:
    s_add_u32 s57, s56, 0
    buffer_load_dwordx4 v[128:131], v2, s[16:19], s57 offen
    s_add_u32 s57, s56, 12288
    buffer_load_dwordx4 v[132:135], v2, s[16:19], s57 offen
    s_add_u32 s57, s56, 24576
    buffer_load_dwordx4 v[136:139], v2, s[16:19], s57 offen
    s_add_u32 s57, s56, 36864
    buffer_load_dwordx4 v[140:143], v2, s[16:19], s57 offen
    s_add_u32 s57, s56, 49152
    buffer_load_dwordx4 v[144:147], v2, s[16:19], s57 offen
    s_add_u32 s57, s56, 61440
    buffer_load_dwordx4 v[148:151], v2, s[16:19], s57 offen
    s_add_u32 s57, s56, 73728
    buffer_load_dwordx4 v[152:155], v2, s[16:19], s57 offen
    s_add_u32 s57, s56, 86016
    buffer_load_dwordx4 v[156:159], v2, s[16:19], s57 offen
    s_waitcnt vmcnt(7)
    v_lshlrev_b32 v24, 16, v128
    v_and_b32 v25, v8, v128
    v_add_f32 v16, v16, v24
    v_add_f32 v17, v17, v25
    v_lshlrev_b32 v24, 16, v129
    v_and_b32 v25, v8, v129
    v_add_f32 v18, v18, v24
    v_add_f32 v19, v19, v25
    v_lshlrev_b32 v24, 16, v130
    v_and_b32 v25, v8, v130
    v_add_f32 v20, v20, v24
    v_add_f32 v21, v21, v25
    v_lshlrev_b32 v24, 16, v131
    v_and_b32 v25, v8, v131
    v_add_f32 v22, v22, v24
    v_add_f32 v23, v23, v25
    s_waitcnt vmcnt(6)
    v_lshlrev_b32 v24, 16, v132
    v_and_b32 v25, v8, v132
    v_add_f32 v16, v16, v24
    v_add_f32 v17, v17, v25
    v_lshlrev_b32 v24, 16, v133
    v_and_b32 v25, v8, v133
    v_add_f32 v18, v18, v24
    v_add_f32 v19, v19, v25
    v_lshlrev_b32 v24, 16, v134
    v_and_b32 v25, v8, v134
    v_add_f32 v20, v20, v24
    v_add_f32 v21, v21, v25
    v_lshlrev_b32 v24, 16, v135
    v_and_b32 v25, v8, v135
    v_add_f32 v22, v22, v24
    v_add_f32 v23, v23, v25
    s_waitcnt vmcnt(5)
    v_lshlrev_b32 v24, 16, v136
    v_and_b32 v25, v8, v136
    v_add_f32 v16, v16, v24
    v_add_f32 v17, v17, v25
    v_lshlrev_b32 v24, 16, v137
    v_and_b32 v25, v8, v137
    v_add_f32 v18, v18, v24
    v_add_f32 v19, v19, v25
    v_lshlrev_b32 v24, 16, v138
    v_and_b32 v25, v8, v138
    v_add_f32 v20, v20, v24
    v_add_f32 v21, v21, v25
    v_lshlrev_b32 v24, 16, v139
    v_and_b32 v25, v8, v139
    v_add_f32 v22, v22, v24
    v_add_f32 v23, v23, v25
    s_waitcnt vmcnt(4)
    v_lshlrev_b32 v24, 16, v140
    v_and_b32 v25, v8, v140
    v_add_f32 v16, v16, v24
    v_add_f32 v17, v17, v25
    v_lshlrev_b32 v24, 16, v141
    v_and_b32 v25, v8, v141
    v_add_f32 v18, v18, v24
    v_add_f32 v19, v19, v25
    v_lshlrev_b32 v24, 16, v142
    v_and_b32 v25, v8, v142
    v_add_f32 v20, v20, v24
    v_add_f32 v21, v21, v25
    v_lshlrev_b32 v24, 16, v143
    v_and_b32 v25, v8, v143
    v_add_f32 v22, v22, v24
    v_add_f32 v23, v23, v25
    s_waitcnt vmcnt(3)
    v_lshlrev_b32 v24, 16, v144
    v_and_b32 v25, v8, v144
    v_add_f32 v16, v16, v24
    v_add_f32 v17, v17, v25
    v_lshlrev_b32 v24, 16, v145
    v_and_b32 v25, v8, v145
    v_add_f32 v18, v18, v24
    v_add_f32 v19, v19, v25
    v_lshlrev_b32 v24, 16, v146
    v_and_b32 v25, v8, v146
    v_add_f32 v20, v20, v24
    v_add_f32 v21, v21, v25
    v_lshlrev_b32 v24, 16, v147
    v_and_b32 v25, v8, v147
    v_add_f32 v22, v22, v24
    v_add_f32 v23, v23, v25
    s_waitcnt vmcnt(2)
    v_lshlrev_b32 v24, 16, v148
    v_and_b32 v25, v8, v148
    v_add_f32 v16, v16, v24
    v_add_f32 v17, v17, v25
    v_lshlrev_b32 v24, 16, v149
    v_and_b32 v25, v8, v149
    v_add_f32 v18, v18, v24
    v_add_f32 v19, v19, v25
    v_lshlrev_b32 v24, 16, v150
    v_and_b32 v25, v8, v150
    v_add_f32 v20, v20, v24
    v_add_f32 v21, v21, v25
    v_lshlrev_b32 v24, 16, v151
    v_and_b32 v25, v8, v151
    v_add_f32 v22, v22, v24
    v_add_f32 v23, v23, v25
    s_waitcnt vmcnt(1)
    v_lshlrev_b32 v24, 16, v152
    v_and_b32 v25, v8, v152
    v_add_f32 v16, v16, v24
    v_add_f32 v17, v17, v25
    v_lshlrev_b32 v24, 16, v153
    v_and_b32 v25, v8, v153
    v_add_f32 v18, v18, v24
    v_add_f32 v19, v19, v25
    v_lshlrev_b32 v24, 16, v154
    v_and_b32 v25, v8, v154
    v_add_f32 v20, v20, v24
    v_add_f32 v21, v21, v25
    v_lshlrev_b32 v24, 16, v155
    v_and_b32 v25, v8, v155
    v_add_f32 v22, v22, v24
    v_add_f32 v23, v23, v25
    s_waitcnt vmcnt(0)
    v_lshlrev_b32 v24, 16, v156
    v_and_b32 v25, v8, v156
    v_add_f32 v16, v16, v24
    v_add_f32 v17, v17, v25
    v_lshlrev_b32 v24, 16, v157
    v_and_b32 v25, v8, v157
    v_add_f32 v18, v18, v24
    v_add_f32 v19, v19, v25
    v_lshlrev_b32 v24, 16, v158
    v_and_b32 v25, v8, v158
    v_add_f32 v20, v20, v24
    v_add_f32 v21, v21, v25
    v_lshlrev_b32 v24, 16, v159
    v_and_b32 v25, v8, v159
    v_add_f32 v22, v22, v24
    v_add_f32 v23, v23, v25
    s_add_u32 s56, s56, 98304
    s_cmp_lt_u32 s56, 50331648
    s_cbranch_scc1 L_alone_loop
    ds_write_b128 v4, v[16:19] offset:0
    ds_write_b128 v4, v[20:23] offset:16
    s_waitcnt lgkmcnt(0)
    s_barrier
    v_cmp_gt_u32 vcc, 96, v0
    s_and_saveexec_b64 s[58:59], vcc
    s_cbranch_execz L_skip_mean
    v_lshlrev_b32 v28, 2, v0
    v_mov_b32 v24, 0
    ds_read_b32 v52, v28 offset:0
    ds_read_b32 v53, v28 offset:384
    ds_read_b32 v54, v28 offset:768
    ds_read_b32 v55, v28 offset:1152
    ds_read_b32 v56, v28 offset:1536
    ds_read_b32 v57, v28 offset:1920
    ds_read_b32 v58, v28 offset:2304
    ds_read_b32 v59, v28 offset:2688
    s_waitcnt lgkmcnt(0)
    v_add_f32 v24, v24, v52
    v_add_f32 v24, v24, v53
    v_add_f32 v24, v24, v54
    v_add_f32 v24, v24, v55
    v_add_f32 v24, v24, v56
    v_add_f32 v24, v24, v57
    v_add_f32 v24, v24, v58
    v_add_f32 v24, v24, v59
    ds_read_b32 v52, v28 offset:3072
    ds_read_b32 v53, v28 offset:3456
    ds_read_b32 v54, v28 offset:3840
    ds_read_b32 v55, v28 offset:4224
    ds_read_b32 v56, v28 offset:4608
    ds_read_b32 v57, v28 offset:4992
    ds_read_b32 v58, v28 offset:5376
    ds_read_b32 v59, v28 offset:5760
    s_waitcnt lgkmcnt(0)
    v_add_f32 v24, v24, v52
    v_add_f32 v24, v24, v53
    v_add_f32 v24, v24, v54
    v_add_f32 v24, v24, v55
    v_add_f32 v24, v24, v56
    v_add_f32 v24, v24, v57
    v_add_f32 v24, v24, v58
    v_add_f32 v24, v24, v59
    ds_read_b32 v52, v28 offset:6144
    ds_read_b32 v53, v28 offset:6528
    ds_read_b32 v54, v28 offset:6912
    ds_read_b32 v55, v28 offset:7296
    ds_read_b32 v56, v28 offset:7680
    ds_read_b32 v57, v28 offset:8064
    ds_read_b32 v58, v28 offset:8448
    ds_read_b32 v59, v28 offset:8832
    s_waitcnt lgkmcnt(0)
    v_add_f32 v24, v24, v52
    v_add_f32 v24, v24, v53
    v_add_f32 v24, v24, v54
    v_add_f32 v24, v24, v55
    v_add_f32 v24, v24, v56
    v_add_f32 v24, v24, v57
    v_add_f32 v24, v24, v58
    v_add_f32 v24, v24, v59
    ds_read_b32 v52, v28 offset:9216
    ds_read_b32 v53, v28 offset:9600
    ds_read_b32 v54, v28 offset:9984
    ds_read_b32 v55, v28 offset:10368
    ds_read_b32 v56, v28 offset:10752
    ds_read_b32 v57, v28 offset:11136
    ds_read_b32 v58, v28 offset:11520
    ds_read_b32 v59, v28 offset:11904
    s_waitcnt lgkmcnt(0)
    v_add_f32 v24, v24, v52
    v_add_f32 v24, v24, v53
    v_add_f32 v24, v24, v54
    v_add_f32 v24, v24, v55
    v_add_f32 v24, v24, v56
    v_add_f32 v24, v24, v57
    v_add_f32 v24, v24, v58
    v_add_f32 v24, v24, v59
    ds_read_b32 v52, v28 offset:12288
    ds_read_b32 v53, v28 offset:12672
    ds_read_b32 v54, v28 offset:13056
    ds_read_b32 v55, v28 offset:13440
    ds_read_b32 v56, v28 offset:13824
    ds_read_b32 v57, v28 offset:14208
    ds_read_b32 v58, v28 offset:14592
    ds_read_b32 v59, v28 offset:14976
    s_waitcnt lgkmcnt(0)
    v_add_f32 v24, v24, v52
    v_add_f32 v24, v24, v53
    v_add_f32 v24, v24, v54
    v_add_f32 v24, v24, v55
    v_add_f32 v24, v24, v56
    v_add_f32 v24, v24, v57
    v_add_f32 v24, v24, v58
    v_add_f32 v24, v24, v59
    ds_read_b32 v52, v28 offset:15360
    ds_read_b32 v53, v28 offset:15744
    ds_read_b32 v54, v28 offset:16128
    ds_read_b32 v55, v28 offset:16512
    ds_read_b32 v56, v28 offset:16896
    ds_read_b32 v57, v28 offset:17280
    ds_read_b32 v58, v28 offset:17664
    ds_read_b32 v59, v28 offset:18048
    s_waitcnt lgkmcnt(0)
    v_add_f32 v24, v24, v52
    v_add_f32 v24, v24, v53
    v_add_f32 v24, v24, v54
    v_add_f32 v24, v24, v55
    v_add_f32 v24, v24, v56
    v_add_f32 v24, v24, v57
    v_add_f32 v24, v24, v58
    v_add_f32 v24, v24, v59
    ds_read_b32 v52, v28 offset:18432
    ds_read_b32 v53, v28 offset:18816
    ds_read_b32 v54, v28 offset:19200
    ds_read_b32 v55, v28 offset:19584
    ds_read_b32 v56, v28 offset:19968
    ds_read_b32 v57, v28 offset:20352
    ds_read_b32 v58, v28 offset:20736
    ds_read_b32 v59, v28 offset:21120
    s_waitcnt lgkmcnt(0)
    v_add_f32 v24, v24, v52
    v_add_f32 v24, v24, v53
    v_add_f32 v24, v24, v54
    v_add_f32 v24, v24, v55
    v_add_f32 v24, v24, v56
    v_add_f32 v24, v24, v57
    v_add_f32 v24, v24, v58
    v_add_f32 v24, v24, v59
    ds_read_b32 v52, v28 offset:21504
    ds_read_b32 v53, v28 offset:21888
    ds_read_b32 v54, v28 offset:22272
    ds_read_b32 v55, v28 offset:22656
    ds_read_b32 v56, v28 offset:23040
    ds_read_b32 v57, v28 offset:23424
    ds_read_b32 v58, v28 offset:23808
    ds_read_b32 v59, v28 offset:24192
    s_waitcnt lgkmcnt(0)
    v_add_f32 v24, v24, v52
    v_add_f32 v24, v24, v53
    v_add_f32 v24, v24, v54
    v_add_f32 v24, v24, v55
    v_add_f32 v24, v24, v56
    v_add_f32 v24, v24, v57
    v_add_f32 v24, v24, v58
    v_add_f32 v24, v24, v59
    s_branch L_mean_tail
L_end:
    s_endpgm
.section .rodata,"a"
.p2align 6
.amdhsa_kernel standalone__channel_attn_se__vision_kernel
  .amdhsa_next_free_vgpr 160
  .amdhsa_next_free_sgpr 82
  .amdhsa_accum_offset 160
  .amdhsa_group_segment_fixed_size 0
  .amdhsa_kernarg_size 48
  .amdhsa_user_sgpr_count 2
  .amdhsa_user_sgpr_kernarg_segment_ptr 1
  .amdhsa_system_sgpr_workgroup_id_x 1
.end_amdhsa_kernel
```
